```python
import torch

def _softmax(x, axis=-1):
    return torch.softmax(x, dim=axis)
def _gelu(x):
    return torch.nn.functional.gelu(x, approximate="tanh")
def _silu(x):
    return torch.nn.functional.silu(x)
def _sigmoid(x):
    return torch.sigmoid(x)
def _layernorm(x, axis=-1, eps=1e-5):
    m = x.mean(dim=axis, keepdim=True)
    v = x.var(dim=axis, keepdim=True, unbiased=False)
    return (x - m) / torch.sqrt(v + eps)
def _scatter_add(tgt, idx, src, axis=0):
    return tgt.clone().index_add_(axis, idx, src)
def _segment_sum(src, seg, n):
    out = torch.zeros((n,) + src.shape[1:], dtype=src.dtype)
    return out.index_add_(0, seg, src)
def _pad(x, pw):
    flat = tuple(v for pair in reversed(pw) for v in pair)
    return torch.nn.functional.pad(x, flat)

kernel_name = 'standalone__self_sup_conv_stem_hubert__speech'

def setup_inputs():

    _w = (lambda a: (lambda t: t.to(torch.bfloat16) if t.is_floating_point() else t)(torch.as_tensor(a)))
    B, T, D, K = 2, 4000, 512, 5
    scale = (1.0 / (K * D)) ** 0.5
    return {
        "x": _w((lambda *s: torch.randn(*s, dtype=torch.bfloat16) * 0.05)(B, T, D)),
        "w": _w((lambda *s: torch.randn(*s, dtype=torch.bfloat16) * 0.05)(K, D, D) * scale),
        "b": _w((lambda *s: torch.randn(*s, dtype=torch.bfloat16) * 0.05)(D) * 0.1),
        "gamma": _w(torch.ones((D,), dtype=float)),
        "beta": _w(torch.zeros((D,), dtype=float)),
    }

def reference(x, w, b, gamma, beta):
    B, T, D = x.shape
    K = w.shape[0]
    s = 2
    L = (T - K) // s + 1
    y = torch.einsum('blc,cd->bld', x[:, 0 : s * L : s, :], w[0])
    for i in range(1, K):
        y = y + torch.einsum('blc,cd->bld', x[:, i : i + s * L : s, :], w[i])
    y = y + b[None, None, :]
    mu = y.mean(1, keepdims=True)
    var = ((y - mu) ** 2).mean(1, keepdims=True)
    yn = (y - mu) / torch.sqrt(var + 1e-5)
    yn = yn * gamma[None, None, :] + beta[None, None, :]
    return _gelu(yn)
```

```asm
; @launch grid=(256,1,1) block=(512,1,1) lds=147968
.amdgcn_target "amdgcn-amd-amdhsa--gfx950"
.text
.globl standalone__self_sup_conv_stem_hubert__speech_kernel
.p2align 8
.type standalone__self_sup_conv_stem_hubert__speech_kernel,@function
standalone__self_sup_conv_stem_hubert__speech_kernel:
    s_cmpk_ge_u32 s2, 256
    s_cbranch_scc1 L_end
    s_load_dwordx16 s[84:99], s[0:1], 0
    v_readfirstlane_b32 s24, v0
    s_getpc_b64 s[4:5]
    v_min_u32 v2, 55, v0
    v_lshlrev_b32 v2, 7, v2
    s_cmp_lg_u32 s24, 0
    s_cbranch_scc1 L_npf
    global_load_dword v159, v2, s[4:5] offset:480
L_npf:
    s_lshr_b32 s26, s2, 4
    s_bfe_u32 s27, s2, 0x10002
    s_and_b32 s3, s2, 3
    s_lshl_b32 s3, s3, 1
    s_bfe_u32 s25, s2, 0x10003
    s_add_u32 s25, s25, s3
    s_lshl1_add_u32 s3, s26, s3
    s_bfe_u32 s34, s24, 0x20006
    s_cmpk_lt_u32 s24, 256
    s_cbranch_scc1 L_compute
    s_mul_i32 s28, s27, 4000
    s_mul_i32 s4, s26, 252
    s_add_u32 s28, s28, s4
    s_lshl_b32 s4, s34, 6
    s_add_u32 s28, s28, s4
    s_lshl_b32 s28, s28, 10
    s_lshl_b32 s29, s34, 7
    s_add_u32 s29, s29, s25
    s_lshl_b32 s29, s29, 7
    s_lshl_b32 s30, s34, 12
    s_lshl_b32 s31, s34, 11
    s_bitset1_b32 s31, 16
    s_lshl_b32 s4, s34, 5
    v_and_b32 v2, 7, v0
    v_and_b32 v3, 56, v0
    v_lshlrev_b32 v2, 4, v2
    v_lshl_or_b32 v18, v3, 8, v2
    v_xor_b32 v18, s4, v18
    v_add_u32 v19, 15360, v18
    v_xor_b32 v4, 16, v19
    v_add_u32 v20, 15360, v4
    v_add_u32 v21, 30720, v4
    v_lshl_or_b32 v22, v3, 7, v2
    v_and_b32 v3, 16, v0
    v_lshlrev_b32 v3, 1, v3
    v_xor_b32 v22, v3, v22
    v_xor_b32 v23, 64, v22
    v_add_u32 v23, 7168, v23
    s_mov_b32 s10, 8192000
    s_mov_b32 s11, 0x20000
    s_mov_b32 s14, 2621440
    s_mov_b32 s15, s11
    s_lshl_b32 s32, s11, 3
    s_and_b32 s3, s3, 7
    s_lshl_b32 s4, s3, 7
    s_add_u32 s4, s4, s28
    s_lshl_b32 s5, s3, 16
    s_add_u32 s5, s5, s29
    s_add_u32 s7, s5, 524288
    s_mov_b32 m0, s31
    s_waitcnt lgkmcnt(0)
    s_mov_b64 s[12:13], s[86:87]
    s_mov_b64 s[8:9], s[84:85]
    buffer_load_dwordx4 v22, s[12:15], s5 offen offset:0 lds
    buffer_load_dwordx4 v23, s[12:15], s5 offen offset:1024 lds
    s_addk_i32 m0, 8192
    s_add_u32 s5, s5, s32
    buffer_load_dwordx4 v22, s[12:15], s5 offen offset:0 lds
    buffer_load_dwordx4 v23, s[12:15], s5 offen offset:1024 lds
    s_addk_i32 m0, 8192
    s_add_u32 s5, s5, s32
    buffer_load_dwordx4 v22, s[12:15], s5 offen offset:0 lds
    buffer_load_dwordx4 v23, s[12:15], s5 offen offset:1024 lds
    s_mov_b32 m0, s30
    s_nop 0
    buffer_load_dwordx4 v18, s[8:11], s4 offen offset:0 lds
    buffer_load_dwordx4 v19, s[8:11], s4 offen offset:1024 lds
    buffer_load_dwordx4 v20, s[8:11], s4 offen offset:2048 lds
    buffer_load_dwordx4 v21, s[8:11], s4 offen offset:3072 lds
    s_addk_i32 m0, 16384
    s_addk_i32 s4, 1024
    buffer_load_dwordx4 v18, s[8:11], s4 offen offset:0 lds
    buffer_load_dwordx4 v19, s[8:11], s4 offen offset:1024 lds
    buffer_load_dwordx4 v20, s[8:11], s4 offen offset:2048 lds
    buffer_load_dwordx4 v21, s[8:11], s4 offen offset:3072 lds
    s_add_u32 m0, s31, 24576
    s_nop 0
    buffer_load_dwordx4 v22, s[12:15], s7 offen offset:0 lds
    buffer_load_dwordx4 v23, s[12:15], s7 offen offset:1024 lds
    s_addk_i32 m0, 8192
    s_add_u32 s7, s7, s32
    buffer_load_dwordx4 v22, s[12:15], s7 offen offset:0 lds
    buffer_load_dwordx4 v23, s[12:15], s7 offen offset:1024 lds
    s_add_u32 m0, s31, 40960
    s_add_u32 s3, s3, 1
    s_and_b32 s3, s3, 7
    s_lshl_b32 s4, s3, 7
    s_add_u32 s4, s4, s28
    s_lshl_b32 s5, s3, 16
    s_add_u32 s5, s5, s29
    s_add_u32 s7, s5, 524288
    s_waitcnt vmcnt(8)
    s_barrier
    buffer_load_dwordx4 v22, s[12:15], s5 offen offset:0 lds
    buffer_load_dwordx4 v23, s[12:15], s5 offen offset:1024 lds
    s_addk_i32 m0, 8192
    s_add_u32 s5, s5, s32
    buffer_load_dwordx4 v22, s[12:15], s5 offen offset:0 lds
    buffer_load_dwordx4 v23, s[12:15], s5 offen offset:1024 lds
    s_addk_i32 m0, 8192
    s_add_u32 s5, s5, s32
    buffer_load_dwordx4 v22, s[12:15], s5 offen offset:0 lds
    buffer_load_dwordx4 v23, s[12:15], s5 offen offset:1024 lds
    s_add_u32 m0, s30, 32768
    s_waitcnt vmcnt(6)
    s_barrier
    buffer_load_dwordx4 v18, s[8:11], s4 offen offset:0 lds
    buffer_load_dwordx4 v19, s[8:11], s4 offen offset:1024 lds
    buffer_load_dwordx4 v20, s[8:11], s4 offen offset:2048 lds
    buffer_load_dwordx4 v21, s[8:11], s4 offen offset:3072 lds
    s_addk_i32 m0, 16384
    s_addk_i32 s4, 1024
    buffer_load_dwordx4 v18, s[8:11], s4 offen offset:0 lds
    buffer_load_dwordx4 v19, s[8:11], s4 offen offset:1024 lds
    buffer_load_dwordx4 v20, s[8:11], s4 offen offset:2048 lds
    buffer_load_dwordx4 v21, s[8:11], s4 offen offset:3072 lds
    s_add_u32 m0, s31, 65536
    s_nop 0
    buffer_load_dwordx4 v22, s[12:15], s7 offen offset:0 lds
    buffer_load_dwordx4 v23, s[12:15], s7 offen offset:1024 lds
    s_addk_i32 m0, 8192
    s_add_u32 s7, s7, s32
    buffer_load_dwordx4 v22, s[12:15], s7 offen offset:0 lds
    buffer_load_dwordx4 v23, s[12:15], s7 offen offset:1024 lds
    s_mov_b32 m0, s31
    s_add_u32 s3, s3, 1
    s_and_b32 s3, s3, 7
    s_lshl_b32 s4, s3, 7
    s_add_u32 s4, s4, s28
    s_lshl_b32 s5, s3, 16
    s_add_u32 s5, s5, s29
    s_add_u32 s7, s5, 524288
    s_waitcnt vmcnt(8)
    s_barrier
    buffer_load_dwordx4 v22, s[12:15], s5 offen offset:0 lds
    buffer_load_dwordx4 v23, s[12:15], s5 offen offset:1024 lds
    s_addk_i32 m0, 8192
    s_add_u32 s5, s5, s32
    buffer_load_dwordx4 v22, s[12:15], s5 offen offset:0 lds
    buffer_load_dwordx4 v23, s[12:15], s5 offen offset:1024 lds
    s_addk_i32 m0, 8192
    s_add_u32 s5, s5, s32
    buffer_load_dwordx4 v22, s[12:15], s5 offen offset:0 lds
    buffer_load_dwordx4 v23, s[12:15], s5 offen offset:1024 lds
    s_mov_b32 m0, s30
    s_waitcnt vmcnt(6)
    s_barrier
    buffer_load_dwordx4 v18, s[8:11], s4 offen offset:0 lds
    buffer_load_dwordx4 v19, s[8:11], s4 offen offset:1024 lds
    buffer_load_dwordx4 v20, s[8:11], s4 offen offset:2048 lds
    buffer_load_dwordx4 v21, s[8:11], s4 offen offset:3072 lds
    s_addk_i32 m0, 16384
    s_addk_i32 s4, 1024
    buffer_load_dwordx4 v18, s[8:11], s4 offen offset:0 lds
    buffer_load_dwordx4 v19, s[8:11], s4 offen offset:1024 lds
    buffer_load_dwordx4 v20, s[8:11], s4 offen offset:2048 lds
    buffer_load_dwordx4 v21, s[8:11], s4 offen offset:3072 lds
    s_add_u32 m0, s31, 24576
    s_nop 0
    buffer_load_dwordx4 v22, s[12:15], s7 offen offset:0 lds
    buffer_load_dwordx4 v23, s[12:15], s7 offen offset:1024 lds
    s_addk_i32 m0, 8192
    s_add_u32 s7, s7, s32
    buffer_load_dwordx4 v22, s[12:15], s7 offen offset:0 lds
    buffer_load_dwordx4 v23, s[12:15], s7 offen offset:1024 lds
    s_add_u32 m0, s31, 40960
    s_add_u32 s3, s3, 1
    s_and_b32 s3, s3, 7
    s_lshl_b32 s4, s3, 7
    s_add_u32 s4, s4, s28
    s_lshl_b32 s5, s3, 16
    s_add_u32 s5, s5, s29
    s_add_u32 s7, s5, 524288
    s_waitcnt vmcnt(8)
    s_barrier
    s_cmp_eq_u32 s34, 0
    s_cbranch_scc1 L_arr
L_arr_ok:
    buffer_load_dwordx4 v22, s[12:15], s5 offen offset:0 lds
    buffer_load_dwordx4 v23, s[12:15], s5 offen offset:1024 lds
    s_addk_i32 m0, 8192
    s_add_u32 s5, s5, s32
    buffer_load_dwordx4 v22, s[12:15], s5 offen offset:0 lds
    buffer_load_dwordx4 v23, s[12:15], s5 offen offset:1024 lds
    s_addk_i32 m0, 8192
    s_add_u32 s5, s5, s32
    buffer_load_dwordx4 v22, s[12:15], s5 offen offset:0 lds
    buffer_load_dwordx4 v23, s[12:15], s5 offen offset:1024 lds
    s_add_u32 m0, s30, 32768
    s_nop 0
    buffer_load_dwordx4 v18, s[8:11], s4 offen offset:0 lds
    buffer_load_dwordx4 v19, s[8:11], s4 offen offset:1024 lds
    buffer_load_dwordx4 v20, s[8:11], s4 offen offset:2048 lds
    buffer_load_dwordx4 v21, s[8:11], s4 offen offset:3072 lds
    s_addk_i32 m0, 16384
    s_addk_i32 s4, 1024
    buffer_load_dwordx4 v18, s[8:11], s4 offen offset:0 lds
    s_waitcnt vmcnt(11)
    s_barrier
    buffer_load_dwordx4 v19, s[8:11], s4 offen offset:1024 lds
    buffer_load_dwordx4 v20, s[8:11], s4 offen offset:2048 lds
    buffer_load_dwordx4 v21, s[8:11], s4 offen offset:3072 lds
    s_add_u32 m0, s31, 65536
    s_nop 0
    buffer_load_dwordx4 v22, s[12:15], s7 offen offset:0 lds
    buffer_load_dwordx4 v23, s[12:15], s7 offen offset:1024 lds
    s_addk_i32 m0, 8192
    s_add_u32 s7, s7, s32
    buffer_load_dwordx4 v22, s[12:15], s7 offen offset:0 lds
    buffer_load_dwordx4 v23, s[12:15], s7 offen offset:1024 lds
    s_mov_b32 m0, s31
    s_add_u32 s3, s3, 1
    s_and_b32 s3, s3, 7
    s_lshl_b32 s4, s3, 7
    s_add_u32 s4, s4, s28
    s_lshl_b32 s5, s3, 16
    s_add_u32 s5, s5, s29
    s_add_u32 s7, s5, 524288
    s_waitcnt vmcnt(8)
    s_barrier
    buffer_load_dwordx4 v22, s[12:15], s5 offen offset:0 lds
    buffer_load_dwordx4 v23, s[12:15], s5 offen offset:1024 lds
    s_addk_i32 m0, 8192
    s_add_u32 s5, s5, s32
    buffer_load_dwordx4 v22, s[12:15], s5 offen offset:0 lds
    buffer_load_dwordx4 v23, s[12:15], s5 offen offset:1024 lds
    s_addk_i32 m0, 8192
    s_add_u32 s5, s5, s32
    buffer_load_dwordx4 v22, s[12:15], s5 offen offset:0 lds
    buffer_load_dwordx4 v23, s[12:15], s5 offen offset:1024 lds
    s_mov_b32 m0, s30
    s_nop 0
    buffer_load_dwordx4 v18, s[8:11], s4 offen offset:0 lds
    buffer_load_dwordx4 v19, s[8:11], s4 offen offset:1024 lds
    buffer_load_dwordx4 v20, s[8:11], s4 offen offset:2048 lds
    buffer_load_dwordx4 v21, s[8:11], s4 offen offset:3072 lds
    s_addk_i32 m0, 16384
    s_addk_i32 s4, 1024
    buffer_load_dwordx4 v18, s[8:11], s4 offen offset:0 lds
    s_waitcnt vmcnt(11)
    s_barrier
    buffer_load_dwordx4 v19, s[8:11], s4 offen offset:1024 lds
    buffer_load_dwordx4 v20, s[8:11], s4 offen offset:2048 lds
    buffer_load_dwordx4 v21, s[8:11], s4 offen offset:3072 lds
    s_add_u32 m0, s31, 24576
    s_nop 0
    buffer_load_dwordx4 v22, s[12:15], s7 offen offset:0 lds
    buffer_load_dwordx4 v23, s[12:15], s7 offen offset:1024 lds
    s_addk_i32 m0, 8192
    s_add_u32 s7, s7, s32
    buffer_load_dwordx4 v22, s[12:15], s7 offen offset:0 lds
    buffer_load_dwordx4 v23, s[12:15], s7 offen offset:1024 lds
    s_add_u32 m0, s31, 40960
    s_add_u32 s3, s3, 1
    s_and_b32 s3, s3, 7
    s_lshl_b32 s4, s3, 7
    s_add_u32 s4, s4, s28
    s_lshl_b32 s5, s3, 16
    s_add_u32 s5, s5, s29
    s_add_u32 s7, s5, 524288
    s_waitcnt vmcnt(8)
    s_barrier
    buffer_load_dwordx4 v22, s[12:15], s5 offen offset:0 lds
    buffer_load_dwordx4 v23, s[12:15], s5 offen offset:1024 lds
    s_addk_i32 m0, 8192
    s_add_u32 s5, s5, s32
    buffer_load_dwordx4 v22, s[12:15], s5 offen offset:0 lds
    buffer_load_dwordx4 v23, s[12:15], s5 offen offset:1024 lds
    s_addk_i32 m0, 8192
    s_add_u32 s5, s5, s32
    buffer_load_dwordx4 v22, s[12:15], s5 offen offset:0 lds
    buffer_load_dwordx4 v23, s[12:15], s5 offen offset:1024 lds
    s_add_u32 m0, s30, 32768
    s_nop 0
    buffer_load_dwordx4 v18, s[8:11], s4 offen offset:0 lds
    buffer_load_dwordx4 v19, s[8:11], s4 offen offset:1024 lds
    buffer_load_dwordx4 v20, s[8:11], s4 offen offset:2048 lds
    buffer_load_dwordx4 v21, s[8:11], s4 offen offset:3072 lds
    s_addk_i32 m0, 16384
    s_addk_i32 s4, 1024
    buffer_load_dwordx4 v18, s[8:11], s4 offen offset:0 lds
    s_waitcnt vmcnt(11)
    s_barrier
    buffer_load_dwordx4 v19, s[8:11], s4 offen offset:1024 lds
    buffer_load_dwordx4 v20, s[8:11], s4 offen offset:2048 lds
    buffer_load_dwordx4 v21, s[8:11], s4 offen offset:3072 lds
    s_add_u32 m0, s31, 65536
    s_nop 0
    buffer_load_dwordx4 v22, s[12:15], s7 offen offset:0 lds
    buffer_load_dwordx4 v23, s[12:15], s7 offen offset:1024 lds
    s_addk_i32 m0, 8192
    s_add_u32 s7, s7, s32
    buffer_load_dwordx4 v22, s[12:15], s7 offen offset:0 lds
    buffer_load_dwordx4 v23, s[12:15], s7 offen offset:1024 lds
    s_mov_b32 m0, s31
    s_add_u32 s3, s3, 1
    s_and_b32 s3, s3, 7
    s_lshl_b32 s4, s3, 7
    s_add_u32 s4, s4, s28
    s_lshl_b32 s5, s3, 16
    s_add_u32 s5, s5, s29
    s_add_u32 s7, s5, 524288
    s_waitcnt vmcnt(8)
    s_barrier
    buffer_load_dwordx4 v22, s[12:15], s5 offen offset:0 lds
    buffer_load_dwordx4 v23, s[12:15], s5 offen offset:1024 lds
    s_addk_i32 m0, 8192
    s_add_u32 s5, s5, s32
    buffer_load_dwordx4 v22, s[12:15], s5 offen offset:0 lds
    buffer_load_dwordx4 v23, s[12:15], s5 offen offset:1024 lds
    s_addk_i32 m0, 8192
    s_add_u32 s5, s5, s32
    buffer_load_dwordx4 v22, s[12:15], s5 offen offset:0 lds
    buffer_load_dwordx4 v23, s[12:15], s5 offen offset:1024 lds
    s_mov_b32 m0, s30
    s_nop 0
    buffer_load_dwordx4 v18, s[8:11], s4 offen offset:0 lds
    buffer_load_dwordx4 v19, s[8:11], s4 offen offset:1024 lds
    buffer_load_dwordx4 v20, s[8:11], s4 offen offset:2048 lds
    buffer_load_dwordx4 v21, s[8:11], s4 offen offset:3072 lds
    s_addk_i32 m0, 16384
    s_addk_i32 s4, 1024
    buffer_load_dwordx4 v18, s[8:11], s4 offen offset:0 lds
    s_waitcnt vmcnt(11)
    s_barrier
    buffer_load_dwordx4 v19, s[8:11], s4 offen offset:1024 lds
    buffer_load_dwordx4 v20, s[8:11], s4 offen offset:2048 lds
    buffer_load_dwordx4 v21, s[8:11], s4 offen offset:3072 lds
    s_add_u32 m0, s31, 24576
    s_nop 0
    buffer_load_dwordx4 v22, s[12:15], s7 offen offset:0 lds
    buffer_load_dwordx4 v23, s[12:15], s7 offen offset:1024 lds
    s_addk_i32 m0, 8192
    s_add_u32 s7, s7, s32
    buffer_load_dwordx4 v22, s[12:15], s7 offen offset:0 lds
    buffer_load_dwordx4 v23, s[12:15], s7 offen offset:1024 lds
    s_add_u32 m0, s31, 40960
    s_add_u32 s3, s3, 1
    s_and_b32 s3, s3, 7
    s_lshl_b32 s4, s3, 7
    s_add_u32 s4, s4, s28
    s_lshl_b32 s5, s3, 16
    s_add_u32 s5, s5, s29
    s_add_u32 s7, s5, 524288
    s_waitcnt vmcnt(8)
    s_barrier
    buffer_load_dwordx4 v22, s[12:15], s5 offen offset:0 lds
    buffer_load_dwordx4 v23, s[12:15], s5 offen offset:1024 lds
    s_addk_i32 m0, 8192
    s_add_u32 s5, s5, s32
    buffer_load_dwordx4 v22, s[12:15], s5 offen offset:0 lds
    buffer_load_dwordx4 v23, s[12:15], s5 offen offset:1024 lds
    s_addk_i32 m0, 8192
    s_add_u32 s5, s5, s32
    buffer_load_dwordx4 v22, s[12:15], s5 offen offset:0 lds
    buffer_load_dwordx4 v23, s[12:15], s5 offen offset:1024 lds
    s_add_u32 m0, s30, 32768
    s_nop 0
    buffer_load_dwordx4 v18, s[8:11], s4 offen offset:0 lds
    buffer_load_dwordx4 v19, s[8:11], s4 offen offset:1024 lds
    buffer_load_dwordx4 v20, s[8:11], s4 offen offset:2048 lds
    buffer_load_dwordx4 v21, s[8:11], s4 offen offset:3072 lds
    s_addk_i32 m0, 16384
    s_addk_i32 s4, 1024
    buffer_load_dwordx4 v18, s[8:11], s4 offen offset:0 lds
    s_waitcnt vmcnt(11)
    s_barrier
    buffer_load_dwordx4 v19, s[8:11], s4 offen offset:1024 lds
    buffer_load_dwordx4 v20, s[8:11], s4 offen offset:2048 lds
    buffer_load_dwordx4 v21, s[8:11], s4 offen offset:3072 lds
    s_add_u32 m0, s31, 65536
    s_nop 0
    buffer_load_dwordx4 v22, s[12:15], s7 offen offset:0 lds
    buffer_load_dwordx4 v23, s[12:15], s7 offen offset:1024 lds
    s_addk_i32 m0, 8192
    s_add_u32 s7, s7, s32
    buffer_load_dwordx4 v22, s[12:15], s7 offen offset:0 lds
    buffer_load_dwordx4 v23, s[12:15], s7 offen offset:1024 lds
    s_waitcnt vmcnt(8)
    s_barrier
    s_branch L_ld2
L_compute:
    v_and_b32 v1, 63, v0
    s_lshl_b32 s35, s27, 3
    s_add_u32 s35, s35, s25
    s_lshl_b32 s36, s35, 2
    s_add_u32 s36, s36, s34
    s_lshl_b32 s36, s36, 11
    s_mov_b32 s22, 262144
    s_mov_b32 s23, 0x20000
    s_mov_b32 s37, 2097152
    s_waitcnt lgkmcnt(0)
    s_mov_b64 s[20:21], s[98:99]
    s_mul_i32 s33, s27, 1998
    s_mul_i32 s6, s26, 126
    s_add_u32 s33, s33, s6
    s_lshl_b32 s33, s33, 10
    s_mov_b32 s18, 129024
    s_cmp_eq_u32 s26, 15
    s_cmov_b32 s18, 110592
    s_add_u32 s18, s18, s33
    s_mov_b32 s19, 0x20000
    s_lshl_b32 s4, s25, 7
    s_add_u32 s33, s33, s4
    s_mov_b64 s[16:17], s[94:95]
    v_mov_b32 v152, 0x409d30fc
    v_mov_b32 v154, 0x3eeff558
    v_mov_b32 v153, v152
    v_mov_b32 v155, v154
    v_lshrrev_b32 v12, 4, v1
    v_and_b32 v15, 15, v0
    v_and_b32 v13, 7, v0
    s_lshl_b32 s4, s24, 8
    v_lshlrev_b32 v156, 10, v12
    v_lshl_add_u32 v156, v15, 3, v156
    v_add_u32 v156, s4, v156
    v_lshlrev_b32 v158, 4, v15
    v_add_u32 v158, 147456, v158
    v_lshrrev_b32 v14, 2, v15
    v_mul_u32_u24 v157, 8512, v14
    v_and_b32 v14, 3, v0
    v_lshl_add_u32 v157, v14, 4, v157
    v_lshl_add_u32 v157, v12, 9, v157
    v_lshrrev_b32 v14, 5, v1
    v_lshl_add_u32 v157, v14, 4, v157
    s_and_b32 s4, s24, 64
    s_lshl_b32 s4, s4, 2
    s_lshr_b32 s6, s24, 7
    s_lshl_b32 s6, s6, 6
    s_add_u32 s4, s4, s6
    s_add_u32 s4, s4, 65536
    v_add_u32 v157, s4, v157
    v_bfe_u32 v2, v1, 2, 2
    v_and_b32 v4, 1, v1
    v_lshl_or_b32 v2, v2, 1, v4
    v_lshrrev_b32 v3, 4, v1
    v_xor_b32 v4, v2, v3
    v_lshlrev_b32 v4, 4, v4
    v_lshl_or_b32 v4, v2, 11, v4
    v_and_b32 v5, 2, v1
    v_lshl_or_b32 v18, v5, 6, v4
    v_xor_b32 v19, 64, v18
    v_bfe_u32 v4, v1, 2, 2
    v_lshl_add_u32 v5, v3, 3, v4
    v_lshlrev_b32 v5, 7, v5
    v_bfe_u32 v6, v1, 3, 2
    v_xor_b32 v6, s34, v6
    v_lshl_add_u32 v5, v6, 5, v5
    v_and_b32 v6, 3, v1
    v_lshl_add_u32 v5, v6, 3, v5
    v_add_u32 v20, 65536, v5
    v_add_u32 v21, 106496, v5
    s_mul_i32 s4, s34, 8512
    s_add_u32 m0, s4, 32768
    v_and_b32 v2, 15, v1
    v_lshrrev_b32 v4, 5, v1
    v_lshlrev_b32 v26, 6, v4
    v_lshl_add_u32 v26, v2, 2, v26
    s_lshl_b32 s4, s26, 7
    s_add_u32 s36, s36, s4
    s_add_u32 s39, s36, 131072
    v_lshlrev_b32 v10, 4, v13
    v_and_b32 v11, 24, v1
    v_lshl_or_b32 v10, v11, 8, v10
    v_lshl_or_b32 v10, v4, 17, v10
    v_mov_b32 v14, -1
    v_mov_b32 v15, -1
    v_mov_b32 v16, -1
    v_mov_b32 v17, -1
    s_cmp_eq_u32 s26, 15
    s_cselect_b32 s28, 0xffff0000, 0
    s_cmp_lg_u32 s24, 0
    s_cbranch_scc1 L_norst
    buffer_store_dwordx4 v[14:17], v10, s[20:23], s36 offen sc1
L_norst:
    v_mov_b64 v[28:29], 0
    v_mov_b64 v[30:31], 0
    v_mov_b64 v[32:33], 0
    v_mov_b64 v[34:35], 0
    v_mov_b64 v[36:37], 0
    v_mov_b64 v[38:39], 0
    v_mov_b64 v[40:41], 0
    v_mov_b64 v[42:43], 0
    v_mov_b64 v[44:45], 0
    v_mov_b64 v[46:47], 0
    v_mov_b64 v[48:49], 0
    v_mov_b64 v[50:51], 0
    v_mov_b64 v[52:53], 0
    v_mov_b64 v[54:55], 0
    v_mov_b64 v[56:57], 0
    v_mov_b64 v[58:59], 0
    v_mov_b64 v[60:61], 0
    v_mov_b64 v[62:63], 0
    v_mov_b64 v[22:23], 0
    v_mov_b64 v[24:25], 0
    s_mov_b32 s38, 4
    s_barrier
    ds_read_b64_tr_b16 v[128:129], v20 offset:0
    ds_read_b64_tr_b16 v[130:131], v20 offset:512
    ds_read_b128 v[64:67], v18 offset:0
    ds_read_b128 v[68:71], v18 offset:256
    ds_read_b128 v[72:75], v18 offset:512
    ds_read_b128 v[76:79], v18 offset:768
    ds_read_b128 v[80:83], v18 offset:1024
    ds_read_b128 v[84:87], v18 offset:1280
    ds_read_b128 v[88:91], v18 offset:1536
    ds_read_b128 v[92:95], v18 offset:1792
    ds_read_b64_tr_b16 v[132:133], v20 offset:8192
    ds_read_b64_tr_b16 v[134:135], v20 offset:8704
    .p2align 3
L_loop:
    s_waitcnt lgkmcnt(9)
    v_mfma_f32_16x16x32_bf16 v[32:35], v[64:67], v[128:131], v[32:35]
    s_waitcnt lgkmcnt(8)
    v_mfma_f32_16x16x32_bf16 v[36:39], v[68:71], v[128:131], v[36:39]
    s_waitcnt lgkmcnt(7)
    v_mfma_f32_16x16x32_bf16 v[40:43], v[72:75], v[128:131], v[40:43]
    s_waitcnt lgkmcnt(6)
    v_mfma_f32_16x16x32_bf16 v[44:47], v[76:79], v[128:131], v[44:47]
    s_waitcnt lgkmcnt(5)
    v_mfma_f32_16x16x32_bf16 v[48:51], v[80:83], v[128:131], v[48:51]
    ds_read_b64_tr_b16 v[136:137], v20 offset:16384
    s_waitcnt lgkmcnt(5)
    v_mfma_f32_16x16x32_bf16 v[52:55], v[84:87], v[128:131], v[52:55]
    ds_read_b64_tr_b16 v[138:139], v20 offset:16896
    s_waitcnt lgkmcnt(5)
    v_mfma_f32_16x16x32_bf16 v[56:59], v[88:91], v[128:131], v[56:59]
    s_waitcnt lgkmcnt(4)
    v_mfma_f32_16x16x32_bf16 v[60:63], v[92:95], v[128:131], v[60:63]
    s_waitcnt lgkmcnt(2)
    v_mfma_f32_16x16x32_bf16 v[30:33], v[64:67], v[132:135], v[30:33]
    v_mfma_f32_16x16x32_bf16 v[34:37], v[68:71], v[132:135], v[34:37]
    v_mfma_f32_16x16x32_bf16 v[38:41], v[72:75], v[132:135], v[38:41]
    ds_read_b64_tr_b16 v[140:141], v20 offset:4096
    v_mfma_f32_16x16x32_bf16 v[42:45], v[76:79], v[132:135], v[42:45]
    ds_read_b64_tr_b16 v[142:143], v20 offset:4608
    v_mfma_f32_16x16x32_bf16 v[46:49], v[80:83], v[132:135], v[46:49]
    ds_read_b128 v[96:99], v19 offset:0
    v_mfma_f32_16x16x32_bf16 v[50:53], v[84:87], v[132:135], v[50:53]
    ds_read_b128 v[100:103], v19 offset:256
    v_mfma_f32_16x16x32_bf16 v[54:57], v[88:91], v[132:135], v[54:57]
    ds_read_b128 v[104:107], v19 offset:512
    v_mfma_f32_16x16x32_bf16 v[58:61], v[92:95], v[132:135], v[58:61]
    ds_read_b128 v[108:111], v19 offset:768
    s_waitcnt lgkmcnt(6)
    v_mfma_f32_16x16x32_bf16 v[28:31], v[64:67], v[136:139], v[28:31]
    ds_read_b128 v[112:115], v19 offset:1024
    v_mfma_f32_16x16x32_bf16 v[32:35], v[68:71], v[136:139], v[32:35]
    ds_read_b128 v[116:119], v19 offset:1280
    v_mfma_f32_16x16x32_bf16 v[36:39], v[72:75], v[136:139], v[36:39]
    ds_read_b128 v[120:123], v19 offset:1536
    v_mfma_f32_16x16x32_bf16 v[40:43], v[76:79], v[136:139], v[40:43]
    ds_read_b128 v[124:127], v19 offset:1792
    v_mfma_f32_16x16x32_bf16 v[44:47], v[80:83], v[136:139], v[44:47]
    ds_read_b64_tr_b16 v[144:145], v20 offset:12288
    v_mfma_f32_16x16x32_bf16 v[48:51], v[84:87], v[136:139], v[48:51]
    ds_read_b64_tr_b16 v[146:147], v20 offset:12800
    v_mfma_f32_16x16x32_bf16 v[52:55], v[88:91], v[136:139], v[52:55]
    v_mfma_f32_16x16x32_bf16 v[56:59], v[92:95], v[136:139], v[56:59]
    s_waitcnt lgkmcnt(9)
    v_mfma_f32_16x16x32_bf16 v[32:35], v[96:99], v[140:143], v[32:35]
    s_waitcnt lgkmcnt(8)
    v_mfma_f32_16x16x32_bf16 v[36:39], v[100:103], v[140:143], v[36:39]
    s_waitcnt lgkmcnt(7)
    v_mfma_f32_16x16x32_bf16 v[40:43], v[104:107], v[140:143], v[40:43]
    s_waitcnt lgkmcnt(6)
    v_mfma_f32_16x16x32_bf16 v[44:47], v[108:111], v[140:143], v[44:47]
    s_waitcnt lgkmcnt(5)
    v_mfma_f32_16x16x32_bf16 v[48:51], v[112:115], v[140:143], v[48:51]
    ds_read_b64_tr_b16 v[148:149], v20 offset:20480
    s_waitcnt lgkmcnt(5)
    v_mfma_f32_16x16x32_bf16 v[52:55], v[116:119], v[140:143], v[52:55]
    ds_read_b64_tr_b16 v[150:151], v20 offset:20992
    s_waitcnt lgkmcnt(5)
    v_mfma_f32_16x16x32_bf16 v[56:59], v[120:123], v[140:143], v[56:59]
    s_waitcnt lgkmcnt(4)
    v_mfma_f32_16x16x32_bf16 v[60:63], v[124:127], v[140:143], v[60:63]
    s_waitcnt lgkmcnt(2)
    v_mfma_f32_16x16x32_bf16 v[30:33], v[96:99], v[144:147], v[30:33]
    v_mfma_f32_16x16x32_bf16 v[34:37], v[100:103], v[144:147], v[34:37]
    v_mfma_f32_16x16x32_bf16 v[38:41], v[104:107], v[144:147], v[38:41]
    s_barrier
    ds_read_b64_tr_b16 v[128:129], v20 offset:24576
    v_mfma_f32_16x16x32_bf16 v[42:45], v[108:111], v[144:147], v[42:45]
    ds_read_b64_tr_b16 v[130:131], v20 offset:25088
    v_mfma_f32_16x16x32_bf16 v[46:49], v[112:115], v[144:147], v[46:49]
    ds_read_b128 v[64:67], v18 offset:16384
    v_mfma_f32_16x16x32_bf16 v[50:53], v[116:119], v[144:147], v[50:53]
    ds_read_b128 v[68:71], v18 offset:16640
    v_mfma_f32_16x16x32_bf16 v[54:57], v[120:123], v[144:147], v[54:57]
    ds_read_b128 v[72:75], v18 offset:16896
    v_mfma_f32_16x16x32_bf16 v[58:61], v[124:127], v[144:147], v[58:61]
    ds_read_b128 v[76:79], v18 offset:17152
    s_waitcnt lgkmcnt(6)
    v_mfma_f32_16x16x32_bf16 v[28:31], v[96:99], v[148:151], v[28:31]
    ds_read_b128 v[80:83], v18 offset:17408
    v_mfma_f32_16x16x32_bf16 v[32:35], v[100:103], v[148:151], v[32:35]
    ds_read_b128 v[84:87], v18 offset:17664
    v_mfma_f32_16x16x32_bf16 v[36:39], v[104:107], v[148:151], v[36:39]
    ds_read_b128 v[88:91], v18 offset:17920
    v_mfma_f32_16x16x32_bf16 v[40:43], v[108:111], v[148:151], v[40:43]
    ds_read_b128 v[92:95], v18 offset:18176
    v_mfma_f32_16x16x32_bf16 v[44:47], v[112:115], v[148:151], v[44:47]
    ds_read_b64_tr_b16 v[132:133], v20 offset:32768
    v_mfma_f32_16x16x32_bf16 v[48:51], v[116:119], v[148:151], v[48:51]
    ds_read_b64_tr_b16 v[134:135], v20 offset:33280
    v_mfma_f32_16x16x32_bf16 v[52:55], v[120:123], v[148:151], v[52:55]
    v_mfma_f32_16x16x32_bf16 v[56:59], v[124:127], v[148:151], v[56:59]
    s_waitcnt lgkmcnt(9)
    v_mfma_f32_16x16x32_bf16 v[32:35], v[64:67], v[128:131], v[32:35]
    s_waitcnt lgkmcnt(8)
    v_mfma_f32_16x16x32_bf16 v[36:39], v[68:71], v[128:131], v[36:39]
    s_waitcnt lgkmcnt(7)
    v_mfma_f32_16x16x32_bf16 v[40:43], v[72:75], v[128:131], v[40:43]
    ds_read_b64_tr_b16 v[140:141], v20 offset:28672
    s_waitcnt lgkmcnt(7)
    v_mfma_f32_16x16x32_bf16 v[44:47], v[76:79], v[128:131], v[44:47]
    ds_read_b64_tr_b16 v[142:143], v20 offset:29184
    s_waitcnt lgkmcnt(7)
    v_mfma_f32_16x16x32_bf16 v[48:51], v[80:83], v[128:131], v[48:51]
    ds_read_b128 v[96:99], v19 offset:16384
    s_waitcnt lgkmcnt(7)
    v_mfma_f32_16x16x32_bf16 v[52:55], v[84:87], v[128:131], v[52:55]
    ds_read_b128 v[100:103], v19 offset:16640
    s_waitcnt lgkmcnt(7)
    v_mfma_f32_16x16x32_bf16 v[56:59], v[88:91], v[128:131], v[56:59]
    ds_read_b128 v[104:107], v19 offset:16896
    s_waitcnt lgkmcnt(7)
    v_mfma_f32_16x16x32_bf16 v[60:63], v[92:95], v[128:131], v[60:63]
    ds_read_b128 v[108:111], v19 offset:17152
    s_waitcnt lgkmcnt(6)
    v_mfma_f32_16x16x32_bf16 v[30:33], v[64:67], v[132:135], v[30:33]
    ds_read_b128 v[112:115], v19 offset:17408
    v_mfma_f32_16x16x32_bf16 v[34:37], v[68:71], v[132:135], v[34:37]
    ds_read_b128 v[116:119], v19 offset:17664
    v_mfma_f32_16x16x32_bf16 v[38:41], v[72:75], v[132:135], v[38:41]
    ds_read_b128 v[120:123], v19 offset:17920
    v_mfma_f32_16x16x32_bf16 v[42:45], v[76:79], v[132:135], v[42:45]
    ds_read_b128 v[124:127], v19 offset:18176
    v_mfma_f32_16x16x32_bf16 v[46:49], v[80:83], v[132:135], v[46:49]
    ds_read_b64_tr_b16 v[144:145], v20 offset:36864
    v_mfma_f32_16x16x32_bf16 v[50:53], v[84:87], v[132:135], v[50:53]
    ds_read_b64_tr_b16 v[146:147], v20 offset:37376
    v_mfma_f32_16x16x32_bf16 v[54:57], v[88:91], v[132:135], v[54:57]
    v_mfma_f32_16x16x32_bf16 v[58:61], v[92:95], v[132:135], v[58:61]
    s_waitcnt lgkmcnt(9)
    v_mfma_f32_16x16x32_bf16 v[32:35], v[96:99], v[140:143], v[32:35]
    s_waitcnt lgkmcnt(8)
    v_mfma_f32_16x16x32_bf16 v[36:39], v[100:103], v[140:143], v[36:39]
    s_waitcnt lgkmcnt(7)
    v_mfma_f32_16x16x32_bf16 v[40:43], v[104:107], v[140:143], v[40:43]
    s_waitcnt lgkmcnt(0)
    s_barrier
    ds_read_b64_tr_b16 v[128:129], v21 offset:0
    v_mfma_f32_16x16x32_bf16 v[44:47], v[108:111], v[140:143], v[44:47]
    ds_read_b64_tr_b16 v[130:131], v21 offset:512
    v_mfma_f32_16x16x32_bf16 v[48:51], v[112:115], v[140:143], v[48:51]
    ds_read_b128 v[64:67], v18 offset:32768
    v_mfma_f32_16x16x32_bf16 v[52:55], v[116:119], v[140:143], v[52:55]
    ds_read_b128 v[68:71], v18 offset:33024
    v_mfma_f32_16x16x32_bf16 v[56:59], v[120:123], v[140:143], v[56:59]
    ds_read_b128 v[72:75], v18 offset:33280
    v_mfma_f32_16x16x32_bf16 v[60:63], v[124:127], v[140:143], v[60:63]
    ds_read_b128 v[76:79], v18 offset:33536
    v_mfma_f32_16x16x32_bf16 v[30:33], v[96:99], v[144:147], v[30:33]
    ds_read_b128 v[80:83], v18 offset:33792
    v_mfma_f32_16x16x32_bf16 v[34:37], v[100:103], v[144:147], v[34:37]
    ds_read_b128 v[84:87], v18 offset:34048
    v_mfma_f32_16x16x32_bf16 v[38:41], v[104:107], v[144:147], v[38:41]
    ds_read_b128 v[88:91], v18 offset:34304
    v_mfma_f32_16x16x32_bf16 v[42:45], v[108:111], v[144:147], v[42:45]
    ds_read_b128 v[92:95], v18 offset:34560
    v_mfma_f32_16x16x32_bf16 v[46:49], v[112:115], v[144:147], v[46:49]
    ds_read_b64_tr_b16 v[132:133], v21 offset:8192
    v_mfma_f32_16x16x32_bf16 v[50:53], v[116:119], v[144:147], v[50:53]
    ds_read_b64_tr_b16 v[134:135], v21 offset:8704
    v_mfma_f32_16x16x32_bf16 v[54:57], v[120:123], v[144:147], v[54:57]
    v_mfma_f32_16x16x32_bf16 v[58:61], v[124:127], v[144:147], v[58:61]
    s_waitcnt lgkmcnt(9)
    v_mfma_f32_16x16x32_bf16 v[32:35], v[64:67], v[128:131], v[32:35]
    s_waitcnt lgkmcnt(8)
    v_mfma_f32_16x16x32_bf16 v[36:39], v[68:71], v[128:131], v[36:39]
    s_waitcnt lgkmcnt(7)
    v_mfma_f32_16x16x32_bf16 v[40:43], v[72:75], v[128:131], v[40:43]
    s_waitcnt lgkmcnt(6)
    v_mfma_f32_16x16x32_bf16 v[44:47], v[76:79], v[128:131], v[44:47]
    s_waitcnt lgkmcnt(5)
    v_mfma_f32_16x16x32_bf16 v[48:51], v[80:83], v[128:131], v[48:51]
    ds_read_b64_tr_b16 v[136:137], v21 offset:16384
    s_waitcnt lgkmcnt(5)
    v_mfma_f32_16x16x32_bf16 v[52:55], v[84:87], v[128:131], v[52:55]
    ds_read_b64_tr_b16 v[138:139], v21 offset:16896
    s_waitcnt lgkmcnt(5)
    v_mfma_f32_16x16x32_bf16 v[56:59], v[88:91], v[128:131], v[56:59]
    s_waitcnt lgkmcnt(4)
    v_mfma_f32_16x16x32_bf16 v[60:63], v[92:95], v[128:131], v[60:63]
    s_waitcnt lgkmcnt(2)
    v_mfma_f32_16x16x32_bf16 v[30:33], v[64:67], v[132:135], v[30:33]
    v_mfma_f32_16x16x32_bf16 v[34:37], v[68:71], v[132:135], v[34:37]
    v_mfma_f32_16x16x32_bf16 v[38:41], v[72:75], v[132:135], v[38:41]
    ds_read_b64_tr_b16 v[140:141], v21 offset:4096
    v_mfma_f32_16x16x32_bf16 v[42:45], v[76:79], v[132:135], v[42:45]
    ds_read_b64_tr_b16 v[142:143], v21 offset:4608
    v_mfma_f32_16x16x32_bf16 v[46:49], v[80:83], v[132:135], v[46:49]
    ds_read_b128 v[96:99], v19 offset:32768
    v_mfma_f32_16x16x32_bf16 v[50:53], v[84:87], v[132:135], v[50:53]
    ds_read_b128 v[100:103], v19 offset:33024
    v_mfma_f32_16x16x32_bf16 v[54:57], v[88:91], v[132:135], v[54:57]
    ds_read_b128 v[104:107], v19 offset:33280
    v_mfma_f32_16x16x32_bf16 v[58:61], v[92:95], v[132:135], v[58:61]
    ds_read_b128 v[108:111], v19 offset:33536
    s_waitcnt lgkmcnt(6)
    v_mfma_f32_16x16x32_bf16 v[28:31], v[64:67], v[136:139], v[28:31]
    ds_read_b128 v[112:115], v19 offset:33792
    v_mfma_f32_16x16x32_bf16 v[32:35], v[68:71], v[136:139], v[32:35]
    ds_read_b128 v[116:119], v19 offset:34048
    v_mfma_f32_16x16x32_bf16 v[36:39], v[72:75], v[136:139], v[36:39]
    ds_read_b128 v[120:123], v19 offset:34304
    v_mfma_f32_16x16x32_bf16 v[40:43], v[76:79], v[136:139], v[40:43]
    ds_read_b128 v[124:127], v19 offset:34560
    v_mfma_f32_16x16x32_bf16 v[44:47], v[80:83], v[136:139], v[44:47]
    ds_read_b64_tr_b16 v[144:145], v21 offset:12288
    v_mfma_f32_16x16x32_bf16 v[48:51], v[84:87], v[136:139], v[48:51]
    ds_read_b64_tr_b16 v[146:147], v21 offset:12800
    v_mfma_f32_16x16x32_bf16 v[52:55], v[88:91], v[136:139], v[52:55]
    v_mfma_f32_16x16x32_bf16 v[56:59], v[92:95], v[136:139], v[56:59]
    s_waitcnt lgkmcnt(9)
    v_mfma_f32_16x16x32_bf16 v[32:35], v[96:99], v[140:143], v[32:35]
    s_waitcnt lgkmcnt(8)
    v_mfma_f32_16x16x32_bf16 v[36:39], v[100:103], v[140:143], v[36:39]
    s_waitcnt lgkmcnt(7)
    v_mfma_f32_16x16x32_bf16 v[40:43], v[104:107], v[140:143], v[40:43]
    s_waitcnt lgkmcnt(6)
    v_mfma_f32_16x16x32_bf16 v[44:47], v[108:111], v[140:143], v[44:47]
    s_waitcnt lgkmcnt(5)
    v_mfma_f32_16x16x32_bf16 v[48:51], v[112:115], v[140:143], v[48:51]
    ds_read_b64_tr_b16 v[148:149], v21 offset:20480
    s_waitcnt lgkmcnt(5)
    v_mfma_f32_16x16x32_bf16 v[52:55], v[116:119], v[140:143], v[52:55]
    ds_read_b64_tr_b16 v[150:151], v21 offset:20992
    s_waitcnt lgkmcnt(5)
    v_mfma_f32_16x16x32_bf16 v[56:59], v[120:123], v[140:143], v[56:59]
    s_waitcnt lgkmcnt(4)
    v_mfma_f32_16x16x32_bf16 v[60:63], v[124:127], v[140:143], v[60:63]
    s_waitcnt lgkmcnt(2)
    v_mfma_f32_16x16x32_bf16 v[30:33], v[96:99], v[144:147], v[30:33]
    v_mfma_f32_16x16x32_bf16 v[34:37], v[100:103], v[144:147], v[34:37]
    v_mfma_f32_16x16x32_bf16 v[38:41], v[104:107], v[144:147], v[38:41]
    s_waitcnt vmcnt(0)
    s_barrier
    ds_read_b64_tr_b16 v[128:129], v21 offset:24576
    v_mfma_f32_16x16x32_bf16 v[42:45], v[108:111], v[144:147], v[42:45]
    ds_read_b64_tr_b16 v[130:131], v21 offset:25088
    v_mfma_f32_16x16x32_bf16 v[46:49], v[112:115], v[144:147], v[46:49]
    ds_read_b128 v[64:67], v18 offset:49152
    v_mfma_f32_16x16x32_bf16 v[50:53], v[116:119], v[144:147], v[50:53]
    ds_read_b128 v[68:71], v18 offset:49408
    v_mfma_f32_16x16x32_bf16 v[54:57], v[120:123], v[144:147], v[54:57]
    ds_read_b128 v[72:75], v18 offset:49664
    v_mfma_f32_16x16x32_bf16 v[58:61], v[124:127], v[144:147], v[58:61]
    ds_read_b128 v[76:79], v18 offset:49920
    s_waitcnt lgkmcnt(6)
    v_mfma_f32_16x16x32_bf16 v[28:31], v[96:99], v[148:151], v[28:31]
    ds_read_b128 v[80:83], v18 offset:50176
    v_mfma_f32_16x16x32_bf16 v[32:35], v[100:103], v[148:151], v[32:35]
    ds_read_b128 v[84:87], v18 offset:50432
    v_mfma_f32_16x16x32_bf16 v[36:39], v[104:107], v[148:151], v[36:39]
    ds_read_b128 v[88:91], v18 offset:50688
    v_mfma_f32_16x16x32_bf16 v[40:43], v[108:111], v[148:151], v[40:43]
    ds_read_b128 v[92:95], v18 offset:50944
    v_mfma_f32_16x16x32_bf16 v[44:47], v[112:115], v[148:151], v[44:47]
    ds_read_b64_tr_b16 v[132:133], v21 offset:32768
    v_mfma_f32_16x16x32_bf16 v[48:51], v[116:119], v[148:151], v[48:51]
    ds_read_b64_tr_b16 v[134:135], v21 offset:33280
    v_mfma_f32_16x16x32_bf16 v[52:55], v[120:123], v[148:151], v[52:55]
    v_mfma_f32_16x16x32_bf16 v[56:59], v[124:127], v[148:151], v[56:59]
    s_waitcnt lgkmcnt(9)
    v_mfma_f32_16x16x32_bf16 v[32:35], v[64:67], v[128:131], v[32:35]
    s_waitcnt lgkmcnt(8)
    v_mfma_f32_16x16x32_bf16 v[36:39], v[68:71], v[128:131], v[36:39]
    s_waitcnt lgkmcnt(7)
    v_mfma_f32_16x16x32_bf16 v[40:43], v[72:75], v[128:131], v[40:43]
    ds_read_b64_tr_b16 v[140:141], v21 offset:28672
    s_waitcnt lgkmcnt(7)
    v_mfma_f32_16x16x32_bf16 v[44:47], v[76:79], v[128:131], v[44:47]
    ds_read_b64_tr_b16 v[142:143], v21 offset:29184
    s_waitcnt lgkmcnt(7)
    v_mfma_f32_16x16x32_bf16 v[48:51], v[80:83], v[128:131], v[48:51]
    ds_read_b128 v[96:99], v19 offset:49152
    s_waitcnt lgkmcnt(7)
    v_mfma_f32_16x16x32_bf16 v[52:55], v[84:87], v[128:131], v[52:55]
    ds_read_b128 v[100:103], v19 offset:49408
    s_waitcnt lgkmcnt(7)
    v_mfma_f32_16x16x32_bf16 v[56:59], v[88:91], v[128:131], v[56:59]
    ds_read_b128 v[104:107], v19 offset:49664
    s_waitcnt lgkmcnt(7)
    v_mfma_f32_16x16x32_bf16 v[60:63], v[92:95], v[128:131], v[60:63]
    ds_read_b128 v[108:111], v19 offset:49920
    s_waitcnt lgkmcnt(6)
    v_mfma_f32_16x16x32_bf16 v[30:33], v[64:67], v[132:135], v[30:33]
    ds_read_b128 v[112:115], v19 offset:50176
    v_mfma_f32_16x16x32_bf16 v[34:37], v[68:71], v[132:135], v[34:37]
    ds_read_b128 v[116:119], v19 offset:50432
    v_mfma_f32_16x16x32_bf16 v[38:41], v[72:75], v[132:135], v[38:41]
    ds_read_b128 v[120:123], v19 offset:50688
    v_mfma_f32_16x16x32_bf16 v[42:45], v[76:79], v[132:135], v[42:45]
    ds_read_b128 v[124:127], v19 offset:50944
    v_mfma_f32_16x16x32_bf16 v[46:49], v[80:83], v[132:135], v[46:49]
    ds_read_b64_tr_b16 v[144:145], v21 offset:36864
    v_mfma_f32_16x16x32_bf16 v[50:53], v[84:87], v[132:135], v[50:53]
    ds_read_b64_tr_b16 v[146:147], v21 offset:37376
    v_mfma_f32_16x16x32_bf16 v[54:57], v[88:91], v[132:135], v[54:57]
    v_mfma_f32_16x16x32_bf16 v[58:61], v[92:95], v[132:135], v[58:61]
    s_waitcnt lgkmcnt(9)
    v_mfma_f32_16x16x32_bf16 v[32:35], v[96:99], v[140:143], v[32:35]
    s_waitcnt lgkmcnt(8)
    v_mfma_f32_16x16x32_bf16 v[36:39], v[100:103], v[140:143], v[36:39]
    s_waitcnt lgkmcnt(7)
    v_mfma_f32_16x16x32_bf16 v[40:43], v[104:107], v[140:143], v[40:43]
    s_waitcnt lgkmcnt(0)
    s_barrier
    ds_read_b64_tr_b16 v[128:129], v20 offset:0
    v_mfma_f32_16x16x32_bf16 v[44:47], v[108:111], v[140:143], v[44:47]
    ds_read_b64_tr_b16 v[130:131], v20 offset:512
    v_mfma_f32_16x16x32_bf16 v[48:51], v[112:115], v[140:143], v[48:51]
    ds_read_b128 v[64:67], v18 offset:0
    v_mfma_f32_16x16x32_bf16 v[52:55], v[116:119], v[140:143], v[52:55]
    ds_read_b128 v[68:71], v18 offset:256
    v_mfma_f32_16x16x32_bf16 v[56:59], v[120:123], v[140:143], v[56:59]
    ds_read_b128 v[72:75], v18 offset:512
    v_mfma_f32_16x16x32_bf16 v[60:63], v[124:127], v[140:143], v[60:63]
    ds_read_b128 v[76:79], v18 offset:768
    v_mfma_f32_16x16x32_bf16 v[30:33], v[96:99], v[144:147], v[30:33]
    ds_read_b128 v[80:83], v18 offset:1024
    v_mfma_f32_16x16x32_bf16 v[34:37], v[100:103], v[144:147], v[34:37]
    ds_read_b128 v[84:87], v18 offset:1280
    v_mfma_f32_16x16x32_bf16 v[38:41], v[104:107], v[144:147], v[38:41]
    ds_read_b128 v[88:91], v18 offset:1536
    v_mfma_f32_16x16x32_bf16 v[42:45], v[108:111], v[144:147], v[42:45]
    ds_read_b128 v[92:95], v18 offset:1792
    v_mfma_f32_16x16x32_bf16 v[46:49], v[112:115], v[144:147], v[46:49]
    ds_read_b64_tr_b16 v[132:133], v20 offset:8192
    v_mfma_f32_16x16x32_bf16 v[50:53], v[116:119], v[144:147], v[50:53]
    ds_read_b64_tr_b16 v[134:135], v20 offset:8704
    v_mfma_f32_16x16x32_bf16 v[54:57], v[120:123], v[144:147], v[54:57]
    s_sub_u32 s38, s38, 1
    v_mfma_f32_16x16x32_bf16 v[58:61], v[124:127], v[144:147], v[58:61]
    s_cmp_lg_u32 s38, 0
    s_cbranch_scc1 L_loop
    .p2align 3
    v_permlane16_swap_b32 v28, v22
    v_permlane16_swap_b32 v30, v23
    v_pk_mul_f32 v[4:5], v[32:33], v[32:33]
    v_pk_add_f32 v[2:3], v[32:33], v[34:35]
    v_permlane32_swap_b32 v28, v24
    v_permlane32_swap_b32 v30, v25
    v_pk_fma_f32 v[4:5], v[34:35], v[34:35], v[4:5]
    v_pk_add_f32 v[2:3], v[2:3], v[36:37]
    v_pk_fma_f32 v[4:5], v[36:37], v[36:37], v[4:5]
    v_permlane16_swap_b32 v22, v24
    v_permlane16_swap_b32 v23, v25
    v_pk_add_f32 v[2:3], v[2:3], v[38:39]
    v_pk_fma_f32 v[4:5], v[38:39], v[38:39], v[4:5]
    v_pk_add_f32 v[2:3], v[2:3], v[40:41]
    v_pk_fma_f32 v[4:5], v[40:41], v[40:41], v[4:5]
    v_pk_add_f32 v[2:3], v[2:3], v[42:43]
    v_pk_fma_f32 v[4:5], v[42:43], v[42:43], v[4:5]
    v_pk_add_f32 v[2:3], v[2:3], v[44:45]
    v_pk_fma_f32 v[4:5], v[44:45], v[44:45], v[4:5]
    v_pk_add_f32 v[2:3], v[2:3], v[46:47]
    v_pk_fma_f32 v[4:5], v[46:47], v[46:47], v[4:5]
    v_pk_add_f32 v[2:3], v[2:3], v[48:49]
    v_pk_fma_f32 v[4:5], v[48:49], v[48:49], v[4:5]
    v_pk_add_f32 v[2:3], v[2:3], v[50:51]
    v_pk_fma_f32 v[4:5], v[50:51], v[50:51], v[4:5]
    v_pk_add_f32 v[2:3], v[2:3], v[52:53]
    v_pk_fma_f32 v[4:5], v[52:53], v[52:53], v[4:5]
    v_pk_add_f32 v[2:3], v[2:3], v[54:55]
    v_pk_fma_f32 v[4:5], v[54:55], v[54:55], v[4:5]
    v_add_f32 v60, v60, v29
    v_add_f32 v62, v62, v31
    v_add_f32 v61, v61, v22
    v_add_f32 v63, v63, v23
    s_mov_b32 exec_lo, 0
    s_mov_b32 exec_hi, 0xffff0000
    v_mov_b32 v61, 0
    v_mov_b32 v63, 0
    s_mov_b32 exec_hi, s28
    v_mov_b32 v3, 0
    v_mov_b32 v5, 0
    v_mov_b64 v[56:57], 0
    v_mov_b64 v[58:59], 0
    v_mov_b32 v60, 0
    v_mov_b32 v62, 0
    s_mov_b64 exec, -1
    .p2align 3
    v_pk_add_f32 v[2:3], v[2:3], v[56:57]
    v_pk_fma_f32 v[4:5], v[56:57], v[56:57], v[4:5]
    v_pk_add_f32 v[2:3], v[2:3], v[58:59]
    v_pk_fma_f32 v[4:5], v[58:59], v[58:59], v[4:5]
    v_pk_add_f32 v[2:3], v[2:3], v[60:61]
    v_pk_fma_f32 v[4:5], v[60:61], v[60:61], v[4:5]
    v_pk_add_f32 v[2:3], v[2:3], v[62:63]
    v_pk_fma_f32 v[4:5], v[62:63], v[62:63], v[4:5]
    v_add_f32 v2, v2, v3
    v_add_f32 v4, v4, v5
    s_nop 1
    v_permlane32_swap_b32 v2, v4
    v_add_f32 v2, v2, v4
    v_add_f32 v4, 0, v2
    s_nop 1
    v_permlane16_swap_b32 v2, v4
    v_add_f32 v2, v2, v4
    v_min_u32 v2, -2, v2
    buffer_store_dword v2, v26, s[20:23], s36 offen
    .p2align 3
    ds_write_addtid_b32 v32 offset:32768
    ds_write_addtid_b32 v33 offset:33024
    ds_write_addtid_b32 v34 offset:33280
    ds_write_addtid_b32 v35 offset:33536
    ds_write_addtid_b32 v36 offset:33808
    ds_write_addtid_b32 v37 offset:34064
    ds_write_addtid_b32 v38 offset:34320
    ds_write_addtid_b32 v39 offset:34576
    ds_write_addtid_b32 v40 offset:34848
    ds_write_addtid_b32 v41 offset:35104
    ds_write_addtid_b32 v42 offset:35360
    ds_write_addtid_b32 v43 offset:35616
    ds_write_addtid_b32 v44 offset:35888
    ds_write_addtid_b32 v45 offset:36144
    ds_write_addtid_b32 v46 offset:36400
    ds_write_addtid_b32 v47 offset:36656
    ds_write_addtid_b32 v48 offset:36928
    ds_write_addtid_b32 v49 offset:37184
    ds_write_addtid_b32 v50 offset:37440
    ds_write_addtid_b32 v51 offset:37696
    ds_write_addtid_b32 v52 offset:37968
    ds_write_addtid_b32 v53 offset:38224
    ds_write_addtid_b32 v54 offset:38480
    ds_write_addtid_b32 v55 offset:38736
    ds_write_addtid_b32 v56 offset:39008
    ds_write_addtid_b32 v57 offset:39264
    ds_write_addtid_b32 v58 offset:39520
    ds_write_addtid_b32 v59 offset:39776
    ds_write_addtid_b32 v60 offset:40048
    ds_write_addtid_b32 v61 offset:40304
    ds_write_addtid_b32 v62 offset:40560
    ds_write_addtid_b32 v63 offset:40816
    s_waitcnt lgkmcnt(0)
    s_barrier
    ds_read_b128 v[64:67], v157 offset:0
    ds_read_b128 v[68:71], v157 offset:2080
    ds_read_b128 v[72:75], v157 offset:4160
    ds_read_b128 v[76:79], v157 offset:6240
    s_branch L_tail
L_ld2:
    v_and_b32 v1, 63, v0
    s_lshl_b32 s35, s27, 3
    s_add_u32 s35, s35, s25
    s_lshl_b32 s36, s35, 2
    s_add_u32 s36, s36, s34
    s_lshl_b32 s36, s36, 11
    s_mov_b32 s22, 262144
    s_mov_b32 s23, 0x20000
    s_mov_b32 s37, 2097152
    s_mov_b64 s[20:21], s[98:99]
    s_mov_b64 s[40:41], s[96:97]
    s_movk_i32 s42, 256
    s_mov_b32 s43, s23
    s_mov_b64 s[44:45], s[90:91]
    s_movk_i32 s46, 1024
    s_mov_b32 s47, s23
    s_mov_b64 s[48:49], s[92:93]
    s_movk_i32 s50, 1024
    s_mov_b32 s51, s23
    v_and_b32 v2, 3, v1
    v_lshrrev_b32 v3, 4, v1
    v_lshl_add_u32 v2, v2, 2, v3
    s_lshl_b32 s4, s34, 4
    v_add_u32 v2, s4, v2
    v_lshlrev_b32 v3, 1, v2
    s_lshl_b32 s4, s35, 4
    v_mov_b32 v7, s4
    s_lshl_b32 s4, s25, 7
    buffer_load_dword v29, v7, s[40:43], 0 offen sc1
    buffer_load_ushort v24, v3, s[44:47], s4 offen
    buffer_load_ushort v25, v3, s[48:51], s4 offen
    v_lshlrev_b32 v28, 2, v2
    v_add_u32 v28, 147456, v28
    v_lshlrev_b32 v27, 4, v1
    s_add_u32 s5, s36, 131072
    buffer_load_dwordx4 v[32:35], v27, s[20:23], s36 offen offset:0 sc1
    buffer_load_dwordx4 v[36:39], v27, s[20:23], s36 offen offset:1024 sc1
    s_mov_b32 s39, 0x1000000
    v_mov_b32 v26, 0
    s_movk_i32 s38, 20
    s_waitcnt vmcnt(5)
    s_barrier
    s_mul_i32 s33, s27, 1998
    s_mul_i32 s6, s26, 126
    s_add_u32 s33, s33, s6
    s_lshl_b32 s33, s33, 10
    s_mov_b32 s18, 129024
    s_cmp_eq_u32 s26, 15
    s_cmov_b32 s18, 110592
    s_add_u32 s18, s18, s33
    s_mov_b32 s19, 0x20000
    s_lshl_b32 s4, s25, 7
    s_add_u32 s33, s33, s4
    s_mov_b64 s[16:17], s[94:95]
    v_mov_b32 v152, 0x409d30fc
    v_mov_b32 v154, 0x3eeff558
    v_mov_b32 v153, v152
    v_mov_b32 v155, v154
    v_lshrrev_b32 v12, 4, v1
    v_and_b32 v15, 15, v0
    v_and_b32 v13, 7, v0
    s_lshl_b32 s4, s24, 8
    v_lshlrev_b32 v156, 10, v12
    v_lshl_add_u32 v156, v15, 3, v156
    v_add_u32 v156, s4, v156
    v_lshlrev_b32 v158, 4, v15
    v_add_u32 v158, 147456, v158
    v_lshrrev_b32 v14, 2, v15
    v_mul_u32_u24 v157, 8512, v14
    v_and_b32 v14, 3, v0
    v_lshl_add_u32 v157, v14, 4, v157
    v_lshl_add_u32 v157, v12, 9, v157
    v_lshrrev_b32 v14, 5, v1
    v_lshl_add_u32 v157, v14, 4, v157
    s_and_b32 s4, s24, 64
    s_lshl_b32 s4, s4, 2
    s_lshr_b32 s6, s24, 7
    s_lshl_b32 s6, s6, 6
    s_add_u32 s4, s4, s6
    s_add_u32 s4, s4, 65536
    v_add_u32 v157, s4, v157
    s_barrier
    s_waitcnt vmcnt(0)
    v_cmp_gt_u32 vcc, 16, v29
    s_cbranch_vccnz L_cnt
L_cntok:
    v_lshlrev_b32 v24, 16, v24
    v_lshlrev_b32 v25, 16, v25
    v_mul_f32 v24, v154, v24
    v_mul_f32 v25, v154, v25
    s_mov_b32 s37, 2097152
    s_barrier
L_p2:
    buffer_load_dwordx4 v[32:35], v27, s[20:23], s36 offen offset:0 sc1
    buffer_load_dwordx4 v[36:39], v27, s[20:23], s36 offen offset:1024 sc1
    ds_read_b128 v[64:67], v157 offset:0
    ds_read_b128 v[68:71], v157 offset:2080
    ds_read_b128 v[72:75], v157 offset:4160
    ds_read_b128 v[76:79], v157 offset:6240
    s_sub_u32 s38, s38, 1
    s_cbranch_scc1 L_fb
L_pc:
    s_waitcnt vmcnt(1)
    v_max3_u32 v2, v32, v33, v34
    v_max_u32 v2, v2, v35
    s_waitcnt vmcnt(0)
    v_max3_u32 v2, v2, v36, v37
    v_max3_u32 v2, v2, v38, v39
    v_cmp_eq_u32 vcc, -1, v2
    v_pk_add_f32 v[32:33], v[32:33], v[36:37]
    v_pk_add_f32 v[34:35], v[34:35], v[38:39]
    s_cbranch_vccnz L_p2
L_p3:
    s_nop 0
    v_permlane32_swap_b32 v32, v34
    v_permlane32_swap_b32 v33, v35
    v_pk_add_f32 v[32:33], v[32:33], v[34:35]
    s_nop 1
    v_permlane16_swap_b32 v32, v33
    v_add_f32 v32, v32, v33
    s_nop 1
    v_add_f32_dpp v32, v32, v32 row_ror:8 row_mask:0xf bank_mask:0xf
    v_mul_f32 v32, 0x3a033405, v32
    s_nop 1
    v_mov_b32_dpp v33, v32 row_ror:4 row_mask:0xf bank_mask:0xf
    v_fma_f32 v33, -v32, v32, v33
    v_max_f32 v33, 0, v33
    v_add_f32 v33, 0x3727c5ac, v33
    v_rsq_f32 v33, v33
    s_mov_b32 exec_lo, 0x000f000f
    s_mov_b32 exec_hi, 0x000f000f
    v_mul_f32 v34, v33, v24
    v_fma_f32 v35, -v32, v34, v25
    ds_write2_b32 v28, v34, v35 offset0:0 offset1:64
    s_mov_b64 exec, -1
    s_waitcnt lgkmcnt(0)
L_tail:
    s_barrier
    ds_read_b128 v[80:83], v158 offset:0
    ds_read_b128 v[88:91], v158 offset:256
    s_add_u32 s5, s33, 8192
    s_add_u32 s6, s33, 4096
    s_add_u32 s7, s33, 12288
    s_waitcnt lgkmcnt(0)
    .p2align 3
    v_pk_fma_f32 v[64:65], v[64:65], v[80:81], v[88:89]
    v_pk_fma_f32 v[66:67], v[66:67], v[82:83], v[90:91]
    v_pk_fma_f32 v[96:97], v[64:65], v[64:65], v[152:153]
    v_pk_fma_f32 v[98:99], v[66:67], v[66:67], v[152:153]
    v_pk_mul_f32 v[96:97], v[96:97], v[64:65]
    v_pk_mul_f32 v[98:99], v[98:99], v[66:67]
    v_exp_f32 v96, -v96
    v_exp_f32 v97, -v97
    v_exp_f32 v98, -v98
    v_exp_f32 v99, -v99
    v_pk_fma_f32 v[96:97], v[96:97], v[154:155], v[154:155]
    v_pk_fma_f32 v[98:99], v[98:99], v[154:155], v[154:155]
    v_rcp_f32_e64 v96, v96
    v_rcp_f32_e64 v97, v97
    v_rcp_f32_e64 v98, v98
    v_rcp_f32_e64 v99, v99
    v_pk_mul_f32 v[96:97], v[96:97], v[64:65]
    v_pk_mul_f32 v[98:99], v[98:99], v[66:67]
    v_cvt_pk_bf16_f32 v112, v96, v97
    v_cvt_pk_bf16_f32 v113, v98, v99
    buffer_store_dwordx2 v[112:113], v156, s[16:19], s33 offen sc1
    buffer_store_dword v2, v26, s[20:23], s39 offen sc1
    v_pk_fma_f32 v[68:69], v[68:69], v[80:81], v[88:89]
    v_pk_fma_f32 v[70:71], v[70:71], v[82:83], v[90:91]
    v_pk_fma_f32 v[100:101], v[68:69], v[68:69], v[152:153]
    v_pk_fma_f32 v[102:103], v[70:71], v[70:71], v[152:153]
    v_pk_mul_f32 v[100:101], v[100:101], v[68:69]
    v_pk_mul_f32 v[102:103], v[102:103], v[70:71]
    v_exp_f32 v100, -v100
    v_exp_f32 v101, -v101
    v_exp_f32 v102, -v102
    v_exp_f32 v103, -v103
    v_pk_fma_f32 v[100:101], v[100:101], v[154:155], v[154:155]
    v_pk_fma_f32 v[102:103], v[102:103], v[154:155], v[154:155]
    v_rcp_f32_e64 v100, v100
    v_rcp_f32_e64 v101, v101
    v_rcp_f32_e64 v102, v102
    v_rcp_f32_e64 v103, v103
    v_pk_mul_f32 v[100:101], v[100:101], v[68:69]
    v_pk_mul_f32 v[102:103], v[102:103], v[70:71]
    v_cvt_pk_bf16_f32 v114, v100, v101
    v_cvt_pk_bf16_f32 v115, v102, v103
    buffer_store_dwordx2 v[114:115], v156, s[16:19], s6 offen sc1
    v_pk_fma_f32 v[72:73], v[72:73], v[80:81], v[88:89]
    v_pk_fma_f32 v[74:75], v[74:75], v[82:83], v[90:91]
    v_pk_fma_f32 v[104:105], v[72:73], v[72:73], v[152:153]
    v_pk_fma_f32 v[106:107], v[74:75], v[74:75], v[152:153]
    v_pk_mul_f32 v[104:105], v[104:105], v[72:73]
    v_pk_mul_f32 v[106:107], v[106:107], v[74:75]
    v_exp_f32 v104, -v104
    v_exp_f32 v105, -v105
    v_exp_f32 v106, -v106
    v_exp_f32 v107, -v107
    v_pk_fma_f32 v[104:105], v[104:105], v[154:155], v[154:155]
    v_pk_fma_f32 v[106:107], v[106:107], v[154:155], v[154:155]
    v_rcp_f32_e64 v104, v104
    v_rcp_f32_e64 v105, v105
    v_rcp_f32_e64 v106, v106
    v_rcp_f32_e64 v107, v107
    v_pk_mul_f32 v[104:105], v[104:105], v[72:73]
    v_pk_mul_f32 v[106:107], v[106:107], v[74:75]
    v_cvt_pk_bf16_f32 v116, v104, v105
    v_cvt_pk_bf16_f32 v117, v106, v107
    buffer_store_dwordx2 v[116:117], v156, s[16:19], s5 offen sc1
    v_pk_fma_f32 v[76:77], v[76:77], v[80:81], v[88:89]
    v_pk_fma_f32 v[78:79], v[78:79], v[82:83], v[90:91]
    v_pk_fma_f32 v[108:109], v[76:77], v[76:77], v[152:153]
    v_pk_fma_f32 v[110:111], v[78:79], v[78:79], v[152:153]
    v_pk_mul_f32 v[108:109], v[108:109], v[76:77]
    v_pk_mul_f32 v[110:111], v[110:111], v[78:79]
    v_exp_f32 v108, -v108
    v_exp_f32 v109, -v109
    v_exp_f32 v110, -v110
    v_exp_f32 v111, -v111
    v_pk_fma_f32 v[108:109], v[108:109], v[154:155], v[154:155]
    v_pk_fma_f32 v[110:111], v[110:111], v[154:155], v[154:155]
    v_rcp_f32_e64 v108, v108
    v_rcp_f32_e64 v109, v109
    v_rcp_f32_e64 v110, v110
    v_rcp_f32_e64 v111, v111
    v_pk_mul_f32 v[108:109], v[108:109], v[76:77]
    v_pk_mul_f32 v[110:111], v[110:111], v[78:79]
    v_cvt_pk_bf16_f32 v118, v108, v109
    v_cvt_pk_bf16_f32 v119, v110, v111
    buffer_store_dwordx2 v[118:119], v156, s[16:19], s7 offen sc1
L_end:
    s_endpgm
L_arr:
    s_lshl_b32 s35, s27, 3
    s_add_u32 s35, s35, s25
    s_lshl_b32 s37, s35, 4
    s_mov_b32 s39, 1
    s_atomic_add s39, s[96:97], s37
    s_branch L_arr_ok
L_cnt:
    buffer_load_dword v29, v7, s[40:43], 0 offen sc1
    s_sub_u32 s37, s37, 1
    s_cbranch_scc1 L_cntok
    s_waitcnt vmcnt(0)
    v_cmp_gt_u32 vcc, 16, v29
    s_cbranch_vccnz L_cnt
    s_branch L_cntok
L_fb:
    s_mov_b32 s38, 0
    s_sub_u32 s37, s37, 1
    s_cbranch_scc1 L_p3
    s_cmp_eq_u32 s36, s5
    s_cbranch_scc1 L_pc
    s_lshl_b32 s4, s26, 7
    s_lshl_b32 s6, s35, 13
    s_add_u32 s4, s4, s6
    v_and_b32 v8, 15, v1
    v_lshlrev_b32 v8, 3, v8
    v_and_b32 v9, 48, v1
    v_lshl_or_b32 v8, v9, 7, v8
    buffer_load_dwordx2 v[10:11], v8, s[20:23], s4 offen sc1
    s_waitcnt vmcnt(0)
    v_max_u32 v9, v10, v11
    v_cmp_eq_u32 vcc, -1, v9
    s_cbranch_vccnz L_fb
    s_add_u32 s4, s4, 131072
    buffer_store_dwordx2 v[10:11], v8, s[20:23], s4 offen sc1
    s_mov_b32 s36, s5
    s_branch L_p2
.section .rodata,"a"
.p2align 6
.amdhsa_kernel standalone__self_sup_conv_stem_hubert__speech_kernel
  .amdhsa_next_free_vgpr 160
  .amdhsa_next_free_sgpr 102
  .amdhsa_accum_offset 160
  .amdhsa_group_segment_fixed_size 0
  .amdhsa_kernarg_size 64
  .amdhsa_user_sgpr_count 2
  .amdhsa_user_sgpr_kernarg_segment_ptr 1
  .amdhsa_system_sgpr_workgroup_id_x 1
.end_amdhsa_kernel
```
